```python
import torch

def _softmax(x, axis=-1):
    return torch.softmax(x, dim=axis)

def _gelu(x):
    return torch.nn.functional.gelu(x, approximate='tanh')

def _silu(x):
    return torch.nn.functional.silu(x)

def _sigmoid(x):
    return torch.sigmoid(x)

def _layernorm(x, axis=-1, eps=1e-05):
    m = x.mean(dim=axis, keepdim=True)
    v = x.var(dim=axis, keepdim=True, unbiased=False)
    return (x - m) / torch.sqrt(v + eps)

def _scatter_add(tgt, idx, src, axis=0):
    return tgt.clone().index_add_(axis, idx, src)

def _segment_sum(src, seg, n):
    out = torch.zeros((n,) + src.shape[1:], dtype=src.dtype)
    return out.index_add_(0, seg, src)

def _pad(x, pw):
    flat = tuple((v for pair in reversed(pw) for v in pair))
    return torch.nn.functional.pad(x, flat)
kernel_name = 'standalone__kv_cache_quant_pre_rope_vs_post_rope__sampling'

def setup_inputs():

    _w = lambda a: (lambda t: t.to(torch.bfloat16) if t.is_floating_point() else t)(torch.as_tensor(a))
    B, Sq, Skv = (8, 4, 8192)
    H, Dh0 = (8, 128)
    G = 64 if 64 > 0 else Dh0
    G = max(2, G // 2 * 2)
    Dh = max(G, Dh0 // G * G)
    Skv = max(Skv, Sq)
    ng = Dh // G
    bits = 8 if 8 > 1 else 4
    bits = max(2, min(8, bits))
    qmax = (1 << bits) - 1
    half = Dh // 2
    inv = 1.0 / 10000.0 ** (torch.arange(half) / max(1, half))
    ang_k = torch.arange(Skv)[:, None] * inv[None, :]
    ang_q = torch.arange(Skv - Sq, Skv)[:, None] * inv[None, :]
    kc = torch.cat([torch.cos(ang_k), torch.cos(ang_k)], dim=-1)
    ks = torch.cat([torch.sin(ang_k), torch.sin(ang_k)], dim=-1)
    qc = torch.cat([torch.cos(ang_q), torch.cos(ang_q)], dim=-1)
    qs = torch.cat([torch.sin(ang_q), torch.sin(ang_q)], dim=-1)
    qk_i = torch.randint(0, qmax + 1, (B, H, Skv, Dh)).to(torch.int32)
    qv_i = torch.randint(0, qmax + 1, (B, H, Skv, Dh)).to(torch.int32)
    ksc = torch.abs((lambda *s: torch.randn(*s, dtype=torch.bfloat16) * 0.05)(B, H, Skv, ng)) * 0.1 + 0.01
    kzp = torch.full((B, H, Skv, ng), qmax / 2.0)
    vsc = torch.abs((lambda *s: torch.randn(*s, dtype=torch.bfloat16) * 0.05)(B, H, Skv, ng)) * 0.1 + 0.01
    vzp = torch.full((B, H, Skv, ng), qmax / 2.0)
    return {'q': _w((lambda *s: torch.randn(*s, dtype=torch.bfloat16) * 0.8)(B, H, Sq, Dh) * 0.5), 'qk': _w(qk_i), 'k_scales': _w(ksc), 'k_zeros': _w(kzp), 'qv': _w(qv_i), 'v_scales': _w(vsc), 'v_zeros': _w(vzp), 'q_cos': _w(qc), 'q_sin': _w(qs), 'k_cos': _w(kc), 'k_sin': _w(ks)}

def reference(q, qk, k_scales, k_zeros, qv, v_scales, v_zeros, q_cos, q_sin, k_cos, k_sin):
    B, H, Sq, Dh = q.shape
    ng = k_scales.shape[-1]
    G = Dh // ng
    half = Dh // 2
    ks = (lambda x, n, axis: torch.repeat_interleave(x, n, dim=axis))(k_scales, G, axis=-1)
    kz = (lambda x, n, axis: torch.repeat_interleave(x, n, dim=axis))(k_zeros, G, axis=-1)
    k = ((lambda x, dt: x.to(dt))(qk, q.dtype) - kz) * ks
    vs = (lambda x, n, axis: torch.repeat_interleave(x, n, dim=axis))(v_scales, G, axis=-1)
    vz = (lambda x, n, axis: torch.repeat_interleave(x, n, dim=axis))(v_zeros, G, axis=-1)
    v = ((lambda x, dt: x.to(dt))(qv, q.dtype) - vz) * vs
    k1 = k[..., :half].clone()
    k2 = k[..., half:].clone()
    krh = torch.concatenate([-k2, k1], axis=-1)
    kr = k * k_cos[None, None, :, :] + krh * k_sin[None, None, :, :]
    q1 = q[..., :half].clone()
    q2 = q[..., half:].clone()
    qrh = torch.concatenate([-q2, q1], axis=-1)
    qr = q * q_cos[None, None, :, :] + qrh * q_sin[None, None, :, :]
    logits = torch.einsum('bhqd,bhkd->bhqk', qr, kr) * float(Dh) ** (-0.5)
    attn = _softmax(logits, axis=-1)
    out = torch.einsum('bhqk,bhkd->bhqd', attn, v)
    return out
```

```asm
; @launch grid=(256,1,1) block=(256,1,1) lds=140288
.amdgcn_target "amdgcn-amd-amdhsa--gfx950"
.text
.globl standalone__kv_cache_quant_pre_rope_vs_post_rope__sampling_kernel
.p2align 8
.type standalone__kv_cache_quant_pre_rope_vs_post_rope__sampling_kernel,@function
standalone__kv_cache_quant_pre_rope_vs_post_rope__sampling_kernel:
s_cmp_ge_u32 s2, 256
s_cbranch_scc1 L_done
s_load_dwordx16 s[48:63], s[0:1], 0
s_load_dwordx8 s[64:71], s[0:1], 64
s_load_dwordx4 s[72:75], s[0:1], 96
v_lshrrev_b32 v56, 6, v0
v_and_b32 v1, 63, v0
s_lshr_b32 s44, s2, 2
v_readfirstlane_b32 s43, v56
s_and_b32 s45, s2, 3
v_lshrrev_b32 v57, 4, v1
v_and_b32 v58, 15, v1
v_lshrrev_b32 v59, 5, v1
v_and_b32 v60, 31, v1
v_lshlrev_b32 v62, 4, v1
v_xor_b32 v61, v60, v59
v_lshlrev_b32 v61, 4, v61
v_lshl_add_u32 v61, v59, 9, v61
v_xor_b32 v2, 0, v61
v_xor_b32 v3, 32, v61
v_xor_b32 v4, 64, v61
v_xor_b32 v5, 96, v61
v_xor_b32 v6, 128, v61
v_add_u32 v6, 4096, v6
v_xor_b32 v7, 160, v61
v_add_u32 v7, 4096, v7
v_xor_b32 v8, 192, v61
v_add_u32 v8, 4096, v8
v_xor_b32 v9, 224, v61
v_add_u32 v9, 4096, v9
v_lshlrev_b32 v14, 4, v58
v_lshl_add_u32 v14, v57, 11, v14
v_xor_b32 v61, v58, v57
v_lshlrev_b32 v61, 4, v61
v_lshl_add_u32 v61, v57, 8, v61
v_xor_b32 v10, 0, v61
v_xor_b32 v11, 64, v61
v_xor_b32 v12, 128, v61
v_xor_b32 v13, 192, v61
v_lshlrev_b32 v15, 2, v58
v_lshlrev_b32 v16, 4, v57
s_lshl_b32 s40, s43, 15
s_mov_b32 s41, s40
s_lshl_b32 s98, s45, 7
s_add_u32 s98, s98, s43
s_add_u32 s96, s98, 4
s_add_u32 s97, s98, 8
s_waitcnt lgkmcnt(0)
s_lshl_b32 s46, s44, 10
s_add_u32 s76, s48, s46
s_addc_u32 s77, s49, 0
s_and_b32 s77, s77, 0xffff
s_mov_b32 s78, 1024
s_mov_b32 s79, 0x20000
s_mov_b32 s80, s62
s_and_b32 s81, s63, 0xffff
s_mov_b32 s82, 1024
s_mov_b32 s83, 0x20000
s_mov_b32 s84, s64
s_and_b32 s85, s65, 0xffff
s_mov_b32 s86, 1024
s_mov_b32 s87, 0x20000
buffer_load_dwordx4 v[84:87], v62, s[76:79], 0 offen
buffer_load_dwordx4 v[88:91], v62, s[80:83], 0 offen
buffer_load_dwordx4 v[92:95], v62, s[84:87], 0 offen
s_lshl_b32 s46, s44, 15
s_add_u32 s20, s52, s46
s_addc_u32 s21, s53, 0
s_and_b32 s21, s21, 0xffff
s_mov_b32 s22, 32768
s_mov_b32 s23, 0x20000
s_add_u32 s24, s54, s46
s_addc_u32 s25, s55, 0
s_and_b32 s25, s25, 0xffff
s_mov_b32 s26, 32768
s_mov_b32 s27, 0x20000
s_lshl_b32 s99, s98, 6
buffer_load_dword v31, v15, s[20:23], s99 offen
buffer_load_dword v32, v15, s[24:27], s99 offen
s_lshl_b32 s46, s44, 22
s_add_u32 s4, s50, s46
s_addc_u32 s5, s51, 0
s_and_b32 s5, s5, 0xffff
s_mov_b32 s6, 4194304
s_mov_b32 s7, 0x20000
s_mov_b32 s12, s66
s_and_b32 s13, s67, 0xffff
s_mov_b32 s14, 2097152
s_mov_b32 s15, 0x20000
s_mov_b32 s16, s68
s_and_b32 s17, s69, 0xffff
s_mov_b32 s18, 2097152
s_mov_b32 s19, 0x20000
s_lshl_b32 s36, s98, 13
s_lshl_b32 s37, s98, 12
s_add_u32 m0, s41, 0
s_nop 0
buffer_load_dwordx4 v2, s[4:7], s36 offen offset:0 nt lds
buffer_load_dwordx4 v3, s[4:7], s36 offen offset:1024 nt lds
buffer_load_dwordx4 v4, s[4:7], s36 offen offset:2048 nt lds
buffer_load_dwordx4 v5, s[4:7], s36 offen offset:3072 nt lds
s_add_u32 m0, s41, 4096
s_nop 0
buffer_load_dwordx4 v6, s[4:7], s36 offen offset:0 nt lds
buffer_load_dwordx4 v7, s[4:7], s36 offen offset:1024 nt lds
buffer_load_dwordx4 v8, s[4:7], s36 offen offset:2048 nt lds
buffer_load_dwordx4 v9, s[4:7], s36 offen offset:3072 nt lds
s_add_u32 m0, s41, 8192
s_nop 0
buffer_load_dwordx4 v10, s[12:15], s37 offen offset:0  lds
buffer_load_dwordx4 v11, s[12:15], s37 offen offset:1024  lds
buffer_load_dwordx4 v12, s[12:15], s37 offen offset:2048  lds
buffer_load_dwordx4 v13, s[12:15], s37 offen offset:3072  lds
s_add_u32 m0, s41, 12288
s_nop 0
buffer_load_dwordx4 v10, s[16:19], s37 offen offset:0  lds
buffer_load_dwordx4 v11, s[16:19], s37 offen offset:1024  lds
buffer_load_dwordx4 v12, s[16:19], s37 offen offset:2048  lds
buffer_load_dwordx4 v13, s[16:19], s37 offen offset:3072  lds
s_xor_b32 s41, s41, 16384
s_lshl_b32 s46, s44, 22
s_add_u32 s8, s56, s46
s_addc_u32 s9, s57, 0
s_and_b32 s9, s9, 0xffff
s_mov_b32 s10, 4194304
s_mov_b32 s11, 0x20000
s_lshl_b32 s46, s44, 15
s_add_u32 s28, s58, s46
s_addc_u32 s29, s59, 0
s_and_b32 s29, s29, 0xffff
s_mov_b32 s30, 32768
s_mov_b32 s31, 0x20000
s_add_u32 s32, s60, s46
s_addc_u32 s33, s61, 0
s_and_b32 s33, s33, 0xffff
s_mov_b32 s34, 32768
s_mov_b32 s35, 0x20000
s_lshl_b32 s36, s96, 13
s_lshl_b32 s37, s96, 12
s_add_u32 m0, s41, 0
s_nop 0
buffer_load_dwordx4 v2, s[4:7], s36 offen offset:0 nt lds
buffer_load_dwordx4 v3, s[4:7], s36 offen offset:1024 nt lds
buffer_load_dwordx4 v4, s[4:7], s36 offen offset:2048 nt lds
buffer_load_dwordx4 v5, s[4:7], s36 offen offset:3072 nt lds
s_add_u32 m0, s41, 4096
s_nop 0
buffer_load_dwordx4 v6, s[4:7], s36 offen offset:0 nt lds
buffer_load_dwordx4 v7, s[4:7], s36 offen offset:1024 nt lds
buffer_load_dwordx4 v8, s[4:7], s36 offen offset:2048 nt lds
buffer_load_dwordx4 v9, s[4:7], s36 offen offset:3072 nt lds
s_add_u32 m0, s41, 8192
s_nop 0
buffer_load_dwordx4 v10, s[12:15], s37 offen offset:0  lds
buffer_load_dwordx4 v11, s[12:15], s37 offen offset:1024  lds
buffer_load_dwordx4 v12, s[12:15], s37 offen offset:2048  lds
buffer_load_dwordx4 v13, s[12:15], s37 offen offset:3072  lds
s_add_u32 m0, s41, 12288
s_nop 0
buffer_load_dwordx4 v10, s[16:19], s37 offen offset:0  lds
buffer_load_dwordx4 v11, s[16:19], s37 offen offset:1024  lds
buffer_load_dwordx4 v12, s[16:19], s37 offen offset:2048  lds
buffer_load_dwordx4 v13, s[16:19], s37 offen offset:3072  lds
s_xor_b32 s41, s41, 16384
s_mov_b32 s80, s72
s_and_b32 s81, s73, 0xffff
s_mov_b32 s82, 256
s_mov_b32 s83, 0x20000
v_mov_b32 v27, 0
v_lshlrev_b32 v61, 1, v57
v_xor_b32 v61, v61, v58
v_lshlrev_b32 v61, 4, v61
v_lshl_add_u32 v61, v58, 9, v61
v_add_u32 v61, s40, v61
v_xor_b32 v17, 0, v61
v_xor_b32 v18, 16, v61
v_xor_b32 v19, 128, v61
v_xor_b32 v20, 144, v61
v_xor_b32 v61, v57, v58
v_lshlrev_b32 v61, 4, v61
v_lshl_add_u32 v61, v58, 8, v61
v_add_u32 v61, s40, v61
v_add_u32 v61, 8192, v61
v_xor_b32 v21, 0, v61
v_xor_b32 v22, 64, v61
v_xor_b32 v23, 128, v61
v_xor_b32 v24, 192, v61
v_bfe_u32 v61, v58, 2, 1
v_mov_b32 v25, 0x01000c0c
v_mov_b32 v63, 0x03020c0c
v_cmp_eq_u32 vcc, 1, v61
s_mov_b32 s42, 0xffff0000
s_mov_b32 s92, 0x3e0293ee
v_cndmask_b32 v25, v25, v63, vcc
v_and_b32 v61, 1, v58
v_mov_b32 v26, 0x05040100
v_mov_b32 v63, 0x07060302
v_cmp_eq_u32 vcc, 1, v61
s_mov_b32 s93, 0x3e0293ee
s_mov_b32 s3, 0
v_cndmask_b32 v26, v26, v63, vcc
v_mov_b32 v34, 0xff800000
v_mov_b32 v36, 0
v_mov_b32 v37, 0
v_mov_b32 v38, 0
v_mov_b32 v39, 0
v_mov_b32 v196, 0
v_mov_b32 v197, 0
v_mov_b32 v198, 0
v_mov_b32 v199, 0
v_mov_b32 v200, 0
v_mov_b32 v201, 0
v_mov_b32 v202, 0
v_mov_b32 v203, 0
v_mov_b32 v204, 0
v_mov_b32 v205, 0
v_mov_b32 v206, 0
v_mov_b32 v207, 0
v_mov_b32 v208, 0
v_mov_b32 v209, 0
v_mov_b32 v210, 0
v_mov_b32 v211, 0
v_mov_b32 v212, 0
v_mov_b32 v213, 0
v_mov_b32 v214, 0
v_mov_b32 v215, 0
v_mov_b32 v216, 0
v_mov_b32 v217, 0
v_mov_b32 v218, 0
v_mov_b32 v219, 0
v_mov_b32 v220, 0
v_mov_b32 v221, 0
v_mov_b32 v222, 0
v_mov_b32 v223, 0
v_mov_b32 v224, 0
v_mov_b32 v225, 0
v_mov_b32 v226, 0
v_mov_b32 v227, 0
v_mov_b32 v228, 0
v_mov_b32 v229, 0
v_mov_b32 v230, 0
v_mov_b32 v231, 0
s_waitcnt vmcnt(32)
v_lshlrev_b32 v40, 16, v31
v_and_b32 v41, s42, v31
v_lshlrev_b32 v42, 16, v32
v_and_b32 v43, s42, v32
v_pk_mul_f32 v[42:43], v[42:43], v[40:41] neg_lo:[1,0] neg_hi:[1,0]
s_lshl_b32 s38, s98, 13
s_lshl_b32 s39, s98, 6
s_lshl_b32 s99, s96, 6
buffer_load_dword v31, v15, s[20:23], s99 offen
buffer_load_dword v32, v15, s[24:27], s99 offen
buffer_load_dwordx4 v[48:51], v16, s[28:31], s39 offen
buffer_load_dwordx4 v[52:55], v16, s[32:35], s39 offen
buffer_load_dwordx4 v[148:151], v14, s[8:11], s38 offen offset:0 nt
buffer_load_dwordx4 v[156:159], v14, s[8:11], s38 offen offset:512 nt
buffer_load_dwordx4 v[164:167], v14, s[8:11], s38 offen offset:1024 nt
buffer_load_dwordx4 v[172:175], v14, s[8:11], s38 offen offset:1536 nt
buffer_load_dwordx4 v[152:155], v14, s[8:11], s38 offen offset:256 nt
buffer_load_dwordx4 v[160:163], v14, s[8:11], s38 offen offset:768 nt
buffer_load_dwordx4 v[168:171], v14, s[8:11], s38 offen offset:1280 nt
buffer_load_dwordx4 v[176:179], v14, s[8:11], s38 offen offset:1792 nt
v_and_b32 v56, 8, v1
v_mov_b32 v57, 0x80008000
v_cmp_eq_u32 vcc, 0, v56
s_nop 1
v_cndmask_b32 v57, 0, v57, vcc
v_mov_b32_dpp v96, v84 row_ror:8 row_mask:0xf bank_mask:0xf
v_xor_b32 v92, v92, v57
v_mov_b32_dpp v97, v85 row_ror:8 row_mask:0xf bank_mask:0xf
v_xor_b32 v93, v93, v57
v_mov_b32_dpp v98, v86 row_ror:8 row_mask:0xf bank_mask:0xf
v_xor_b32 v94, v94, v57
v_mov_b32_dpp v99, v87 row_ror:8 row_mask:0xf bank_mask:0xf
v_xor_b32 v95, v95, v57
v_lshlrev_b32 v116, 16, v84
v_and_b32 v117, s42, v84
v_lshlrev_b32 v118, 16, v88
v_and_b32 v119, s42, v88
v_lshlrev_b32 v120, 16, v96
v_and_b32 v121, s42, v96
v_lshlrev_b32 v122, 16, v92
v_and_b32 v123, s42, v92
v_pk_mul_f32 v[124:125], v[116:117], v[118:119]
v_pk_fma_f32 v[124:125], v[120:121], v[122:123], v[124:125]
v_cvt_pk_bf16_f32 v100, v124, v125
v_lshlrev_b32 v116, 16, v85
v_and_b32 v117, s42, v85
v_lshlrev_b32 v118, 16, v89
v_and_b32 v119, s42, v89
v_lshlrev_b32 v120, 16, v97
v_and_b32 v121, s42, v97
v_lshlrev_b32 v122, 16, v93
v_and_b32 v123, s42, v93
v_pk_mul_f32 v[124:125], v[116:117], v[118:119]
v_pk_fma_f32 v[124:125], v[120:121], v[122:123], v[124:125]
v_cvt_pk_bf16_f32 v101, v124, v125
v_lshlrev_b32 v116, 16, v86
v_and_b32 v117, s42, v86
v_lshlrev_b32 v118, 16, v90
v_and_b32 v119, s42, v90
v_lshlrev_b32 v120, 16, v98
v_and_b32 v121, s42, v98
v_lshlrev_b32 v122, 16, v94
v_and_b32 v123, s42, v94
v_pk_mul_f32 v[124:125], v[116:117], v[118:119]
v_pk_fma_f32 v[124:125], v[120:121], v[122:123], v[124:125]
v_cvt_pk_bf16_f32 v102, v124, v125
v_lshlrev_b32 v116, 16, v87
v_and_b32 v117, s42, v87
v_lshlrev_b32 v118, 16, v91
v_and_b32 v119, s42, v91
v_lshlrev_b32 v120, 16, v99
v_and_b32 v121, s42, v99
v_lshlrev_b32 v122, 16, v95
v_and_b32 v123, s42, v95
v_pk_mul_f32 v[124:125], v[116:117], v[118:119]
v_pk_fma_f32 v[124:125], v[120:121], v[122:123], v[124:125]
v_cvt_pk_bf16_f32 v103, v124, v125
v_and_b32 v56, 3, v1
v_lshlrev_b32 v56, 4, v56
v_lshrrev_b32 v57, 4, v1
v_add_u32 v56, v56, v57
v_lshlrev_b32 v56, 2, v56
v_add_u32 v58, 0, v56
v_add_u32 v59, 32, v56
v_add_u32 v60, 16, v56
v_add_u32 v61, 48, v56
ds_bpermute_b32 v116, v58, v100
ds_bpermute_b32 v117, v58, v101
ds_bpermute_b32 v118, v58, v102
ds_bpermute_b32 v119, v58, v103
ds_bpermute_b32 v120, v59, v100
ds_bpermute_b32 v121, v59, v101
ds_bpermute_b32 v122, v59, v102
ds_bpermute_b32 v123, v59, v103
ds_bpermute_b32 v124, v60, v100
ds_bpermute_b32 v125, v60, v101
ds_bpermute_b32 v126, v60, v102
ds_bpermute_b32 v127, v60, v103
ds_bpermute_b32 v128, v61, v100
ds_bpermute_b32 v129, v61, v101
ds_bpermute_b32 v130, v61, v102
ds_bpermute_b32 v131, v61, v103
s_waitcnt lgkmcnt(0)
v_accvgpr_write_b32 a0, v116
v_accvgpr_write_b32 a1, v117
v_accvgpr_write_b32 a2, v118
v_accvgpr_write_b32 a3, v119
v_accvgpr_write_b32 a4, v120
v_accvgpr_write_b32 a5, v121
v_accvgpr_write_b32 a6, v122
v_accvgpr_write_b32 a7, v123
v_accvgpr_write_b32 a8, v124
v_accvgpr_write_b32 a9, v125
v_accvgpr_write_b32 a10, v126
v_accvgpr_write_b32 a11, v127
v_accvgpr_write_b32 a12, v128
v_accvgpr_write_b32 a13, v129
v_accvgpr_write_b32 a14, v130
v_accvgpr_write_b32 a15, v131
.p2align 6
L_loop:
s_waitcnt vmcnt(28)
ds_read_b128 v[84:87], v17 offset:0
ds_read_b128 v[88:91], v18 offset:0
ds_read_b128 v[116:119], v21
ds_read_b128 v[132:135], v21 offset:4096
ds_read_b128 v[92:95], v17 offset:256
ds_read_b128 v[96:99], v18 offset:256
ds_read_b128 v[120:123], v23
ds_read_b128 v[136:139], v23 offset:4096
ds_read_b128 v[100:103], v19 offset:0
ds_read_b128 v[104:107], v20 offset:0
ds_read_b128 v[124:127], v22
ds_read_b128 v[140:143], v22 offset:4096
ds_read_b128 v[108:111], v19 offset:256
ds_read_b128 v[112:115], v20 offset:256
ds_read_b128 v[128:131], v24
ds_read_b128 v[144:147], v24 offset:4096
s_waitcnt lgkmcnt(0)
v_xor_b32 v17, 0x4000, v17
v_xor_b32 v18, 0x4000, v18
v_xor_b32 v19, 0x4000, v19
v_xor_b32 v20, 0x4000, v20
v_xor_b32 v21, 0x4000, v21
v_xor_b32 v22, 0x4000, v22
v_xor_b32 v23, 0x4000, v23
v_xor_b32 v24, 0x4000, v24
v_cvt_f32_i32 v84, v84
v_cvt_f32_i32 v85, v85
v_cvt_f32_i32 v92, v92
s_cmp_lt_u32 s97, 512
s_cbranch_scc0 L_sk0
s_lshl_b32 s36, s97, 13
s_lshl_b32 s37, s97, 12
s_add_u32 m0, s41, 0
s_nop 0
buffer_load_dwordx4 v2, s[4:7], s36 offen offset:0 nt lds
buffer_load_dwordx4 v3, s[4:7], s36 offen offset:1024 nt lds
buffer_load_dwordx4 v4, s[4:7], s36 offen offset:2048 nt lds
buffer_load_dwordx4 v5, s[4:7], s36 offen offset:3072 nt lds
L_sk0:
v_cvt_f32_i32 v93, v93
v_lshlrev_b32 v56, 16, v116
v_and_b32 v57, s42, v116
v_lshlrev_b32 v58, 16, v132
v_and_b32 v59, s42, v132
v_pk_fma_f32 v[84:85], v[84:85], v[40:41], v[42:43] op_sel_hi:[1,0,0]
v_pk_fma_f32 v[92:93], v[92:93], v[40:41], v[42:43] op_sel:[0,1,1] op_sel_hi:[1,1,1]
v_lshlrev_b32 v60, 16, v120
v_and_b32 v61, s42, v120
v_lshlrev_b32 v62, 16, v136
v_and_b32 v63, s42, v136
v_pk_mul_f32 v[64:65], v[84:85], v[56:57]
v_pk_mul_f32 v[66:67], v[92:93], v[60:61]
v_pk_fma_f32 v[64:65], v[92:93], v[58:59], v[64:65] neg_lo:[1,0,0] neg_hi:[1,0,0]
v_pk_fma_f32 v[66:67], v[84:85], v[62:63], v[66:67]
v_cvt_pk_bf16_f32 v116, v64, v65
v_cvt_pk_bf16_f32 v120, v66, v67
v_cvt_f32_i32 v86, v86
v_cvt_f32_i32 v87, v87
v_cvt_f32_i32 v94, v94
v_cvt_f32_i32 v95, v95
v_lshlrev_b32 v56, 16, v117
v_and_b32 v57, s42, v117
v_lshlrev_b32 v58, 16, v133
v_and_b32 v59, s42, v133
v_pk_fma_f32 v[86:87], v[86:87], v[40:41], v[42:43] op_sel_hi:[1,0,0]
v_pk_fma_f32 v[94:95], v[94:95], v[40:41], v[42:43] op_sel:[0,1,1] op_sel_hi:[1,1,1]
v_lshlrev_b32 v60, 16, v121
v_and_b32 v61, s42, v121
v_lshlrev_b32 v62, 16, v137
v_and_b32 v63, s42, v137
v_pk_mul_f32 v[64:65], v[86:87], v[56:57]
v_pk_mul_f32 v[66:67], v[94:95], v[60:61]
v_pk_fma_f32 v[64:65], v[94:95], v[58:59], v[64:65] neg_lo:[1,0,0] neg_hi:[1,0,0]
v_pk_fma_f32 v[66:67], v[86:87], v[62:63], v[66:67]
v_cvt_pk_bf16_f32 v117, v64, v65
v_cvt_pk_bf16_f32 v121, v66, v67
v_cvt_f32_i32 v88, v88
v_cvt_f32_i32 v89, v89
v_cvt_f32_i32 v96, v96
s_cmp_lt_u32 s97, 512
s_cbranch_scc0 L_sk1
s_add_u32 m0, s41, 4096
s_nop 0
buffer_load_dwordx4 v6, s[4:7], s36 offen offset:0 nt lds
buffer_load_dwordx4 v7, s[4:7], s36 offen offset:1024 nt lds
buffer_load_dwordx4 v8, s[4:7], s36 offen offset:2048 nt lds
buffer_load_dwordx4 v9, s[4:7], s36 offen offset:3072 nt lds
L_sk1:
v_cvt_f32_i32 v97, v97
v_lshlrev_b32 v56, 16, v118
v_and_b32 v57, s42, v118
v_lshlrev_b32 v58, 16, v134
v_and_b32 v59, s42, v134
v_pk_fma_f32 v[88:89], v[88:89], v[40:41], v[42:43] op_sel_hi:[1,0,0]
v_pk_fma_f32 v[96:97], v[96:97], v[40:41], v[42:43] op_sel:[0,1,1] op_sel_hi:[1,1,1]
v_lshlrev_b32 v60, 16, v122
v_and_b32 v61, s42, v122
v_lshlrev_b32 v62, 16, v138
v_and_b32 v63, s42, v138
v_pk_mul_f32 v[64:65], v[88:89], v[56:57]
v_pk_mul_f32 v[66:67], v[96:97], v[60:61]
v_pk_fma_f32 v[64:65], v[96:97], v[58:59], v[64:65] neg_lo:[1,0,0] neg_hi:[1,0,0]
v_pk_fma_f32 v[66:67], v[88:89], v[62:63], v[66:67]
v_cvt_pk_bf16_f32 v118, v64, v65
v_cvt_pk_bf16_f32 v122, v66, v67
v_cvt_f32_i32 v90, v90
v_cvt_f32_i32 v91, v91
v_cvt_f32_i32 v98, v98
v_cvt_f32_i32 v99, v99
v_lshlrev_b32 v56, 16, v119
v_and_b32 v57, s42, v119
v_lshlrev_b32 v58, 16, v135
v_and_b32 v59, s42, v135
v_pk_fma_f32 v[90:91], v[90:91], v[40:41], v[42:43] op_sel_hi:[1,0,0]
v_pk_fma_f32 v[98:99], v[98:99], v[40:41], v[42:43] op_sel:[0,1,1] op_sel_hi:[1,1,1]
v_lshlrev_b32 v60, 16, v123
v_and_b32 v61, s42, v123
v_lshlrev_b32 v62, 16, v139
v_and_b32 v63, s42, v139
v_pk_mul_f32 v[64:65], v[90:91], v[56:57]
v_pk_mul_f32 v[66:67], v[98:99], v[60:61]
v_pk_fma_f32 v[64:65], v[98:99], v[58:59], v[64:65] neg_lo:[1,0,0] neg_hi:[1,0,0]
v_pk_fma_f32 v[66:67], v[90:91], v[62:63], v[66:67]
v_cvt_pk_bf16_f32 v119, v64, v65
v_cvt_pk_bf16_f32 v123, v66, v67
s_nop 1
v_mfma_f32_16x16x32_bf16 v[68:71], v[116:119], a[0:3], 0
v_mfma_f32_16x16x32_bf16 v[68:71], v[120:123], a[4:7], v[68:71]
s_cmp_lt_u32 s97, 512
s_cbranch_scc0 L_sk2
s_add_u32 m0, s41, 8192
s_nop 0
buffer_load_dwordx4 v10, s[12:15], s37 offen offset:0  lds
buffer_load_dwordx4 v11, s[12:15], s37 offen offset:1024  lds
buffer_load_dwordx4 v12, s[12:15], s37 offen offset:2048  lds
buffer_load_dwordx4 v13, s[12:15], s37 offen offset:3072  lds
L_sk2:
v_cvt_f32_i32 v100, v100
v_cvt_f32_i32 v101, v101
v_cvt_f32_i32 v108, v108
v_cvt_f32_i32 v109, v109
v_lshlrev_b32 v56, 16, v124
v_and_b32 v57, s42, v124
v_lshlrev_b32 v58, 16, v140
v_and_b32 v59, s42, v140
v_pk_fma_f32 v[100:101], v[100:101], v[40:41], v[42:43] op_sel_hi:[1,0,0]
v_pk_fma_f32 v[108:109], v[108:109], v[40:41], v[42:43] op_sel:[0,1,1] op_sel_hi:[1,1,1]
v_lshlrev_b32 v60, 16, v128
v_and_b32 v61, s42, v128
v_lshlrev_b32 v62, 16, v144
v_and_b32 v63, s42, v144
v_pk_mul_f32 v[64:65], v[100:101], v[56:57]
v_pk_mul_f32 v[66:67], v[108:109], v[60:61]
v_pk_fma_f32 v[64:65], v[108:109], v[58:59], v[64:65] neg_lo:[1,0,0] neg_hi:[1,0,0]
v_pk_fma_f32 v[66:67], v[100:101], v[62:63], v[66:67]
v_cvt_pk_bf16_f32 v124, v64, v65
v_cvt_pk_bf16_f32 v128, v66, v67
v_cvt_f32_i32 v102, v102
v_cvt_f32_i32 v103, v103
v_cvt_f32_i32 v110, v110
v_cvt_f32_i32 v111, v111
v_lshlrev_b32 v56, 16, v125
v_and_b32 v57, s42, v125
v_lshlrev_b32 v58, 16, v141
v_and_b32 v59, s42, v141
v_pk_fma_f32 v[102:103], v[102:103], v[40:41], v[42:43] op_sel_hi:[1,0,0]
v_pk_fma_f32 v[110:111], v[110:111], v[40:41], v[42:43] op_sel:[0,1,1] op_sel_hi:[1,1,1]
v_lshlrev_b32 v60, 16, v129
v_and_b32 v61, s42, v129
v_lshlrev_b32 v62, 16, v145
v_and_b32 v63, s42, v145
v_pk_mul_f32 v[64:65], v[102:103], v[56:57]
v_pk_mul_f32 v[66:67], v[110:111], v[60:61]
v_pk_fma_f32 v[64:65], v[110:111], v[58:59], v[64:65] neg_lo:[1,0,0] neg_hi:[1,0,0]
v_pk_fma_f32 v[66:67], v[102:103], v[62:63], v[66:67]
v_cvt_pk_bf16_f32 v125, v64, v65
v_cvt_pk_bf16_f32 v129, v66, v67
s_cmp_lt_u32 s97, 512
s_cbranch_scc0 L_sk3
s_add_u32 m0, s41, 12288
s_nop 0
buffer_load_dwordx4 v10, s[16:19], s37 offen offset:0  lds
buffer_load_dwordx4 v11, s[16:19], s37 offen offset:1024  lds
buffer_load_dwordx4 v12, s[16:19], s37 offen offset:2048  lds
buffer_load_dwordx4 v13, s[16:19], s37 offen offset:3072  lds
L_sk3:
s_xor_b32 s41, s41, 16384
v_cvt_f32_i32 v104, v104
v_cvt_f32_i32 v105, v105
v_cvt_f32_i32 v112, v112
v_cvt_f32_i32 v113, v113
v_lshlrev_b32 v56, 16, v126
v_and_b32 v57, s42, v126
v_lshlrev_b32 v58, 16, v142
v_and_b32 v59, s42, v142
v_pk_fma_f32 v[104:105], v[104:105], v[40:41], v[42:43] op_sel_hi:[1,0,0]
v_pk_fma_f32 v[112:113], v[112:113], v[40:41], v[42:43] op_sel:[0,1,1] op_sel_hi:[1,1,1]
v_lshlrev_b32 v60, 16, v130
v_and_b32 v61, s42, v130
v_lshlrev_b32 v62, 16, v146
v_and_b32 v63, s42, v146
v_pk_mul_f32 v[64:65], v[104:105], v[56:57]
v_pk_mul_f32 v[66:67], v[112:113], v[60:61]
v_pk_fma_f32 v[64:65], v[112:113], v[58:59], v[64:65] neg_lo:[1,0,0] neg_hi:[1,0,0]
v_pk_fma_f32 v[66:67], v[104:105], v[62:63], v[66:67]
v_cvt_pk_bf16_f32 v126, v64, v65
v_cvt_pk_bf16_f32 v130, v66, v67
v_cvt_f32_i32 v106, v106
v_cvt_f32_i32 v107, v107
v_cvt_f32_i32 v114, v114
v_cvt_f32_i32 v115, v115
v_lshlrev_b32 v56, 16, v127
v_and_b32 v57, s42, v127
v_lshlrev_b32 v58, 16, v143
v_and_b32 v59, s42, v143
v_pk_fma_f32 v[106:107], v[106:107], v[40:41], v[42:43] op_sel_hi:[1,0,0]
v_pk_fma_f32 v[114:115], v[114:115], v[40:41], v[42:43] op_sel:[0,1,1] op_sel_hi:[1,1,1]
v_lshlrev_b32 v60, 16, v131
v_and_b32 v61, s42, v131
v_lshlrev_b32 v62, 16, v147
v_and_b32 v63, s42, v147
v_pk_mul_f32 v[64:65], v[106:107], v[56:57]
v_pk_mul_f32 v[66:67], v[114:115], v[60:61]
v_pk_fma_f32 v[64:65], v[114:115], v[58:59], v[64:65] neg_lo:[1,0,0] neg_hi:[1,0,0]
v_pk_fma_f32 v[66:67], v[106:107], v[62:63], v[66:67]
v_cvt_pk_bf16_f32 v127, v64, v65
v_cvt_pk_bf16_f32 v131, v66, v67
s_nop 1
v_mfma_f32_16x16x32_bf16 v[68:71], v[124:127], a[8:11], v[68:71]
v_mfma_f32_16x16x32_bf16 v[68:71], v[128:131], a[12:15], v[68:71]
s_nop 7
v_max3_f32 v64, v68, v69, v70
v_max_f32 v64, v64, v71
v_cmp_gt_f32 vcc, v64, v34
s_cbranch_vccnz L_slow
L_back:
v_pk_fma_f32 v[68:69], v[68:69], s[92:93], v[38:39] op_sel_hi:[1,1,0] neg_lo:[0,0,1] neg_hi:[0,0,1]
v_pk_fma_f32 v[70:71], v[70:71], s[92:93], v[38:39] op_sel_hi:[1,1,0] neg_lo:[0,0,1] neg_hi:[0,0,1]
v_exp_f32 v68, v68
v_exp_f32 v69, v69
v_exp_f32 v70, v70
v_exp_f32 v71, v71
s_cmp_lt_u32 s97, 512
s_cbranch_scc1 L_w16
s_waitcnt vmcnt(0)
L_w16:
s_waitcnt vmcnt(16)
v_lshlrev_b32 v40, 16, v31
v_and_b32 v41, s42, v31
v_lshlrev_b32 v42, 16, v32
v_and_b32 v43, s42, v32
v_pk_mul_f32 v[42:43], v[42:43], v[40:41] neg_lo:[1,0] neg_hi:[1,0]
v_perm_b32 v72, v48, v48, v25
v_perm_b32 v73, v49, v49, v25
v_perm_b32 v74, v50, v50, v25
v_perm_b32 v75, v51, v51, v25
v_perm_b32 v44, v53, v52, v26
v_perm_b32 v45, v55, v54, v26
s_cmp_lt_u32 s96, 512
s_cbranch_scc0 L_sk4
s_lshl_b32 s38, s96, 13
s_lshl_b32 s39, s96, 6
s_lshl_b32 s99, s97, 6
buffer_load_dword v31, v15, s[20:23], s99 offen
buffer_load_dword v32, v15, s[24:27], s99 offen
buffer_load_dwordx4 v[48:51], v16, s[28:31], s39 offen
buffer_load_dwordx4 v[52:55], v16, s[32:35], s39 offen
L_sk4:
v_pk_mul_f32 v[72:73], v[72:73], v[68:69]
v_pk_mul_f32 v[74:75], v[74:75], v[70:71]
v_pk_add_f32 v[68:69], v[68:69], v[70:71]
v_cvt_pk_bf16_f32 v76, v72, v73
v_cvt_pk_bf16_f32 v77, v74, v75
v_pk_add_f32 v[36:37], v[36:37], v[68:69]
s_add_u32 s3, s3, 1
v_cvt_f32_i32 v148, v148
v_cvt_f32_i32 v149, v149
v_cvt_f32_i32 v150, v150
v_cvt_f32_i32 v151, v151
v_cvt_f32_i32 v156, v156
v_cvt_f32_i32 v157, v157
v_cvt_f32_i32 v158, v158
v_cvt_f32_i32 v159, v159
v_cvt_f32_i32 v164, v164
v_cvt_f32_i32 v165, v165
v_cvt_f32_i32 v166, v166
v_cvt_f32_i32 v167, v167
v_cvt_f32_i32 v172, v172
v_cvt_f32_i32 v173, v173
v_cvt_f32_i32 v174, v174
v_cvt_f32_i32 v175, v175
v_cvt_pk_bf16_f32 v180, v148, v156
v_cvt_pk_bf16_f32 v181, v164, v172
v_cvt_pk_bf16_f32 v182, v149, v157
v_cvt_pk_bf16_f32 v183, v165, v173
v_cvt_pk_bf16_f32 v184, v150, v158
v_cvt_pk_bf16_f32 v185, v166, v174
v_cvt_pk_bf16_f32 v186, v151, v159
v_cvt_pk_bf16_f32 v187, v167, v175
s_cmp_lt_u32 s96, 512
s_cbranch_scc0 L_sk5
buffer_load_dwordx4 v[148:151], v14, s[8:11], s38 offen offset:0 nt
buffer_load_dwordx4 v[156:159], v14, s[8:11], s38 offen offset:512 nt
buffer_load_dwordx4 v[164:167], v14, s[8:11], s38 offen offset:1024 nt
buffer_load_dwordx4 v[172:175], v14, s[8:11], s38 offen offset:1536 nt
L_sk5:
v_mfma_f32_16x16x16_bf16 v[196:199], v[180:181], v[76:77], v[196:199]
v_mfma_f32_16x16x16_bf16 v[200:203], v[182:183], v[76:77], v[200:203]
v_mfma_f32_16x16x16_bf16 v[204:207], v[184:185], v[76:77], v[204:207]
v_mfma_f32_16x16x16_bf16 v[208:211], v[186:187], v[76:77], v[208:211]
v_cvt_f32_i32 v152, v152
v_cvt_f32_i32 v153, v153
v_cvt_f32_i32 v154, v154
v_cvt_f32_i32 v155, v155
v_cvt_f32_i32 v160, v160
v_cvt_f32_i32 v161, v161
v_cvt_f32_i32 v162, v162
v_cvt_f32_i32 v163, v163
v_cvt_f32_i32 v168, v168
v_cvt_f32_i32 v169, v169
v_cvt_f32_i32 v170, v170
v_cvt_f32_i32 v171, v171
v_cvt_f32_i32 v176, v176
v_cvt_f32_i32 v177, v177
v_cvt_f32_i32 v178, v178
v_cvt_f32_i32 v179, v179
v_cvt_pk_bf16_f32 v188, v152, v160
v_cvt_pk_bf16_f32 v189, v168, v176
v_cvt_pk_bf16_f32 v190, v153, v161
v_cvt_pk_bf16_f32 v191, v169, v177
v_cvt_pk_bf16_f32 v192, v154, v162
v_cvt_pk_bf16_f32 v193, v170, v178
v_cvt_pk_bf16_f32 v194, v155, v163
v_cvt_pk_bf16_f32 v195, v171, v179
s_cmp_lt_u32 s96, 512
s_cbranch_scc0 L_sk6
buffer_load_dwordx4 v[152:155], v14, s[8:11], s38 offen offset:256 nt
buffer_load_dwordx4 v[160:163], v14, s[8:11], s38 offen offset:768 nt
buffer_load_dwordx4 v[168:171], v14, s[8:11], s38 offen offset:1280 nt
buffer_load_dwordx4 v[176:179], v14, s[8:11], s38 offen offset:1792 nt
L_sk6:
s_nop 0
v_mfma_f32_16x16x16_bf16 v[212:215], v[188:189], v[76:77], v[212:215]
v_mfma_f32_16x16x16_bf16 v[216:219], v[190:191], v[76:77], v[216:219]
v_mfma_f32_16x16x16_bf16 v[220:223], v[192:193], v[76:77], v[220:223]
v_mfma_f32_16x16x16_bf16 v[224:227], v[194:195], v[76:77], v[224:227]
v_mfma_f32_16x16x16_bf16 v[228:231], v[44:45], v[76:77], v[228:231]
s_mov_b32 s98, s96
s_mov_b32 s96, s97
s_add_u32 s97, s97, 4
s_cmp_lt_u32 s3, 30
s_cselect_b32 s97, s97, 512
s_cmp_lt_u32 s98, 512
s_cbranch_scc1 L_loop
v_add_f32 v35, v36, v37
v_mov_b32 v56, v35
s_nop 1
v_permlane16_swap_b32 v35, v56
s_nop 1
v_add_f32 v35, v35, v56
v_mov_b32 v56, v35
s_nop 1
v_permlane32_swap_b32 v35, v56
s_nop 1
v_add_f32 v35, v35, v56
s_mul_i32 s46, s43, 2304
s_add_u32 s46, s46, 131072
v_and_b32 v56, 15, v1
v_lshrrev_b32 v57, 4, v1
v_and_b32 v58, 3, v56
v_bfe_u32 v59, v56, 2, 1
v_lshlrev_b32 v60, 9, v58
v_lshl_add_u32 v60, v59, 8, v60
v_lshl_add_u32 v60, v57, 4, v60
v_add_u32 v60, s46, v60
v_lshlrev_b32 v61, 3, v58
v_add_u32 v61, s46, v61
v_cmp_eq_u32 vcc, 1, v59
s_nop 1
v_cndmask_b32 v84, v196, v212, vcc
v_cndmask_b32 v85, v197, v213, vcc
v_cndmask_b32 v86, v198, v214, vcc
v_cndmask_b32 v87, v199, v215, vcc
v_cndmask_b32 v88, v200, v216, vcc
v_cndmask_b32 v89, v201, v217, vcc
v_cndmask_b32 v90, v202, v218, vcc
v_cndmask_b32 v91, v203, v219, vcc
v_cndmask_b32 v92, v204, v220, vcc
v_cndmask_b32 v93, v205, v221, vcc
v_cndmask_b32 v94, v206, v222, vcc
v_cndmask_b32 v95, v207, v223, vcc
v_cndmask_b32 v96, v208, v224, vcc
v_cndmask_b32 v97, v209, v225, vcc
v_cndmask_b32 v98, v210, v226, vcc
v_cndmask_b32 v99, v211, v227, vcc
v_cndmask_b32 v62, v228, v229, vcc
v_pk_add_f32 v[84:85], v[84:85], v[62:63] op_sel_hi:[1,0] neg_lo:[0,1] neg_hi:[0,1]
v_pk_add_f32 v[86:87], v[86:87], v[62:63] op_sel_hi:[1,0] neg_lo:[0,1] neg_hi:[0,1]
v_pk_add_f32 v[88:89], v[88:89], v[62:63] op_sel_hi:[1,0] neg_lo:[0,1] neg_hi:[0,1]
v_pk_add_f32 v[90:91], v[90:91], v[62:63] op_sel_hi:[1,0] neg_lo:[0,1] neg_hi:[0,1]
v_pk_add_f32 v[92:93], v[92:93], v[62:63] op_sel_hi:[1,0] neg_lo:[0,1] neg_hi:[0,1]
v_pk_add_f32 v[94:95], v[94:95], v[62:63] op_sel_hi:[1,0] neg_lo:[0,1] neg_hi:[0,1]
v_pk_add_f32 v[96:97], v[96:97], v[62:63] op_sel_hi:[1,0] neg_lo:[0,1] neg_hi:[0,1]
v_pk_add_f32 v[98:99], v[98:99], v[62:63] op_sel_hi:[1,0] neg_lo:[0,1] neg_hi:[0,1]
ds_write_b128 v60, v[84:87] offset:0
ds_write_b128 v60, v[88:91] offset:64
ds_write_b128 v60, v[92:95] offset:128
ds_write_b128 v60, v[96:99] offset:192
ds_write_b64 v61, v[34:35] offset:2048
s_waitcnt lgkmcnt(0)
s_barrier
v_lshrrev_b32 v56, 5, v1
v_and_b32 v57, 1, v1
v_bfe_u32 v58, v1, 1, 4
v_lshlrev_b32 v56, 8, v56
v_lshl_add_u32 v56, v57, 7, v56
v_lshl_add_u32 v56, v58, 2, v56
s_lshl_b32 s46, s43, 9
s_add_u32 s46, s46, 131072
v_add_u32 v56, s46, v56
s_lshl_b32 s47, s43, 3
s_add_u32 s47, s47, 133120
v_mov_b32 v57, s47
ds_read_b32 v84, v56 offset:0
ds_read_b32 v85, v56 offset:64
ds_read_b64 v[92:93], v57 offset:0
ds_read_b32 v86, v56 offset:2304
ds_read_b32 v87, v56 offset:2368
ds_read_b64 v[94:95], v57 offset:2304
ds_read_b32 v88, v56 offset:4608
ds_read_b32 v89, v56 offset:4672
ds_read_b64 v[96:97], v57 offset:4608
ds_read_b32 v90, v56 offset:6912
ds_read_b32 v91, v56 offset:6976
ds_read_b64 v[98:99], v57 offset:6912
s_lshl_b32 s46, s2, 12
s_add_u32 s84, s74, s46
s_addc_u32 s85, s75, 0
s_and_b32 s85, s85, 0xffff
s_mov_b32 s86, 4096
s_mov_b32 s87, 0x20000
s_waitcnt lgkmcnt(0)
v_max3_f32 v100, v92, v94, v96
v_max_f32 v100, v100, v98
v_sub_f32 v92, v92, v100
v_mul_f32 v92, s92, v92
v_exp_f32 v92, v92
v_sub_f32 v94, v94, v100
v_mul_f32 v94, s92, v94
v_exp_f32 v94, v94
v_sub_f32 v96, v96, v100
v_mul_f32 v96, s92, v96
v_exp_f32 v96, v96
v_sub_f32 v98, v98, v100
v_mul_f32 v98, s92, v98
v_exp_f32 v98, v98
s_nop 0
v_mul_f32 v104, v84, v92
v_mul_f32 v105, v85, v92
v_mul_f32 v103, v93, v92
v_fmac_f32 v104, v86, v94
v_fmac_f32 v105, v87, v94
v_fmac_f32 v103, v95, v94
v_fmac_f32 v104, v88, v96
v_fmac_f32 v105, v89, v96
v_fmac_f32 v103, v97, v96
v_fmac_f32 v104, v90, v98
v_fmac_f32 v105, v91, v98
v_fmac_f32 v103, v99, v98
s_lshl_b32 s46, s43, 9
v_lshlrev_b32 v56, 3, v1
v_add_u32 v56, s46, v56
buffer_store_dwordx2 v[104:105], v56, s[84:87], 0 offen sc1
v_mov_b32 v106, v100
v_mov_b32 v107, v103
s_lshl_b32 s46, s43, 3
s_add_u32 s46, s46, 2048
v_mov_b32 v57, s46
s_mov_b64 exec, 1
buffer_store_dwordx2 v[106:107], v57, s[84:87], 0 offen sc1
s_mov_b64 exec, -1
s_waitcnt vmcnt(0)
s_barrier
s_cmp_lg_u32 s43, 0
s_cbranch_scc1 L_done
s_lshl_b32 s46, s44, 2
v_mov_b32 v56, s46
v_mov_b32 v57, 1
s_mov_b64 exec, 1
buffer_atomic_add v57, v56, s[80:83], 0 offen sc0
s_waitcnt vmcnt(0)
s_mov_b64 exec, -1
v_readfirstlane_b32 s46, v57
s_nop 3
s_and_b32 s46, s46, 0xff
s_cmp_lg_u32 s46, 3
s_cbranch_scc1 L_done
s_lshl_b32 s46, s44, 14
s_add_u32 s76, s74, s46
s_addc_u32 s77, s75, 0
s_and_b32 s77, s77, 0xffff
s_mov_b32 s78, 16384
s_mov_b32 s79, 0x20000
v_lshrrev_b32 v56, 4, v1
v_and_b32 v57, 15, v1
v_lshlrev_b32 v58, 9, v56
v_lshl_add_u32 v58, v57, 5, v58
v_lshlrev_b32 v59, 3, v56
v_add_u32 v59, 2048, v59
s_mov_b32 s47, 0
buffer_load_dwordx4 v[84:87], v58, s[76:79], s47 offen sc1
buffer_load_dwordx4 v[88:91], v58, s[76:79], s47 offen offset:16 sc1
buffer_load_dwordx2 v[116:117], v59, s[76:79], s47 offen sc1
s_mov_b32 s47, 4096
buffer_load_dwordx4 v[92:95], v58, s[76:79], s47 offen sc1
buffer_load_dwordx4 v[96:99], v58, s[76:79], s47 offen offset:16 sc1
buffer_load_dwordx2 v[118:119], v59, s[76:79], s47 offen sc1
s_mov_b32 s47, 8192
buffer_load_dwordx4 v[100:103], v58, s[76:79], s47 offen sc1
buffer_load_dwordx4 v[104:107], v58, s[76:79], s47 offen offset:16 sc1
buffer_load_dwordx2 v[120:121], v59, s[76:79], s47 offen sc1
s_mov_b32 s47, 12288
buffer_load_dwordx4 v[108:111], v58, s[76:79], s47 offen sc1
buffer_load_dwordx4 v[112:115], v58, s[76:79], s47 offen offset:16 sc1
buffer_load_dwordx2 v[122:123], v59, s[76:79], s47 offen sc1
s_lshl_b32 s46, s44, 10
s_add_u32 s80, s70, s46
s_addc_u32 s81, s71, 0
s_and_b32 s81, s81, 0xffff
s_mov_b32 s82, 1024
s_mov_b32 s83, 0x20000
s_waitcnt vmcnt(0)
v_max3_f32 v124, v116, v118, v120
v_max_f32 v124, v124, v122
v_sub_f32 v116, v116, v124
v_mul_f32 v116, s92, v116
v_exp_f32 v116, v116
v_sub_f32 v118, v118, v124
v_mul_f32 v118, s92, v118
v_exp_f32 v118, v118
v_sub_f32 v120, v120, v124
v_mul_f32 v120, s92, v120
v_exp_f32 v120, v120
v_sub_f32 v122, v122, v124
v_mul_f32 v122, s92, v122
v_exp_f32 v122, v122
s_nop 0
v_mul_f32 v125, v117, v116
v_fmac_f32 v125, v119, v118
v_fmac_f32 v125, v121, v120
v_fmac_f32 v125, v123, v122
v_rcp_f32 v125, v125
v_mul_f32 v132, v84, v116
v_fmac_f32 v132, v92, v118
v_fmac_f32 v132, v100, v120
v_fmac_f32 v132, v108, v122
v_mul_f32 v133, v85, v116
v_fmac_f32 v133, v93, v118
v_fmac_f32 v133, v101, v120
v_fmac_f32 v133, v109, v122
v_mul_f32 v134, v86, v116
v_fmac_f32 v134, v94, v118
v_fmac_f32 v134, v102, v120
v_fmac_f32 v134, v110, v122
v_mul_f32 v135, v87, v116
v_fmac_f32 v135, v95, v118
v_fmac_f32 v135, v103, v120
v_fmac_f32 v135, v111, v122
v_mul_f32 v136, v88, v116
v_fmac_f32 v136, v96, v118
v_fmac_f32 v136, v104, v120
v_fmac_f32 v136, v112, v122
v_mul_f32 v137, v89, v116
v_fmac_f32 v137, v97, v118
v_fmac_f32 v137, v105, v120
v_fmac_f32 v137, v113, v122
v_mul_f32 v138, v90, v116
v_fmac_f32 v138, v98, v118
v_fmac_f32 v138, v106, v120
v_fmac_f32 v138, v114, v122
v_mul_f32 v139, v91, v116
v_fmac_f32 v139, v99, v118
v_fmac_f32 v139, v107, v120
v_fmac_f32 v139, v115, v122
v_mul_f32 v132, v132, v125
v_mul_f32 v133, v133, v125
v_mul_f32 v134, v134, v125
v_mul_f32 v135, v135, v125
v_mul_f32 v136, v136, v125
v_mul_f32 v137, v137, v125
v_mul_f32 v138, v138, v125
v_mul_f32 v139, v139, v125
v_cvt_pk_bf16_f32 v140, v132, v133
v_cvt_pk_bf16_f32 v141, v134, v135
v_cvt_pk_bf16_f32 v142, v136, v137
v_cvt_pk_bf16_f32 v143, v138, v139
v_lshlrev_b32 v56, 4, v1
buffer_store_dwordx4 v[140:143], v56, s[80:83], 0 offen
s_waitcnt vmcnt(0)
L_done:
s_endpgm
L_slow:
v_mov_b32 v65, v64
s_nop 1
v_permlane16_swap_b32 v64, v65
s_nop 1
v_max_f32 v64, v64, v65
v_mov_b32 v65, v64
s_nop 1
v_permlane32_swap_b32 v64, v65
s_nop 1
v_max_f32 v64, v64, v65
v_max_f32 v64, v64, v34
v_sub_f32 v66, v34, v64
v_mul_f32 v66, s92, v66
v_exp_f32 v66, v66
v_mov_b32 v34, v64
v_mul_f32 v38, s92, v64
v_pk_mul_f32 v[36:37], v[36:37], v[66:67] op_sel_hi:[1,0]
v_pk_mul_f32 v[196:197], v[196:197], v[66:67] op_sel_hi:[1,0]
v_pk_mul_f32 v[198:199], v[198:199], v[66:67] op_sel_hi:[1,0]
v_pk_mul_f32 v[200:201], v[200:201], v[66:67] op_sel_hi:[1,0]
v_pk_mul_f32 v[202:203], v[202:203], v[66:67] op_sel_hi:[1,0]
v_pk_mul_f32 v[204:205], v[204:205], v[66:67] op_sel_hi:[1,0]
v_pk_mul_f32 v[206:207], v[206:207], v[66:67] op_sel_hi:[1,0]
v_pk_mul_f32 v[208:209], v[208:209], v[66:67] op_sel_hi:[1,0]
v_pk_mul_f32 v[210:211], v[210:211], v[66:67] op_sel_hi:[1,0]
v_pk_mul_f32 v[212:213], v[212:213], v[66:67] op_sel_hi:[1,0]
v_pk_mul_f32 v[214:215], v[214:215], v[66:67] op_sel_hi:[1,0]
v_pk_mul_f32 v[216:217], v[216:217], v[66:67] op_sel_hi:[1,0]
v_pk_mul_f32 v[218:219], v[218:219], v[66:67] op_sel_hi:[1,0]
v_pk_mul_f32 v[220:221], v[220:221], v[66:67] op_sel_hi:[1,0]
v_pk_mul_f32 v[222:223], v[222:223], v[66:67] op_sel_hi:[1,0]
v_pk_mul_f32 v[224:225], v[224:225], v[66:67] op_sel_hi:[1,0]
v_pk_mul_f32 v[226:227], v[226:227], v[66:67] op_sel_hi:[1,0]
v_pk_mul_f32 v[228:229], v[228:229], v[66:67] op_sel_hi:[1,0]
v_pk_mul_f32 v[230:231], v[230:231], v[66:67] op_sel_hi:[1,0]
s_branch L_back
.section .rodata,"a"
.p2align 6
.amdhsa_kernel standalone__kv_cache_quant_pre_rope_vs_post_rope__sampling_kernel
  .amdhsa_next_free_vgpr 248
  .amdhsa_next_free_sgpr 100
  .amdhsa_accum_offset 232
  .amdhsa_group_segment_fixed_size 0
  .amdhsa_kernarg_size 112
  .amdhsa_user_sgpr_count 2
  .amdhsa_user_sgpr_kernarg_segment_ptr 1
  .amdhsa_system_sgpr_workgroup_id_x 1
.end_amdhsa_kernel
```
